```python
import torch

def _softmax(x, axis=-1):
    return torch.softmax(x, dim=axis)
def _gelu(x):
    return torch.nn.functional.gelu(x, approximate="tanh")
def _silu(x):
    return torch.nn.functional.silu(x)
def _sigmoid(x):
    return torch.sigmoid(x)
def _layernorm(x, axis=-1, eps=1e-5):
    m = x.mean(dim=axis, keepdim=True)
    v = x.var(dim=axis, keepdim=True, unbiased=False)
    return (x - m) / torch.sqrt(v + eps)
def _scatter_add(tgt, idx, src, axis=0):
    return tgt.clone().index_add_(axis, idx, src)
def _segment_sum(src, seg, n):
    out = torch.zeros((n,) + src.shape[1:], dtype=src.dtype)
    return out.index_add_(0, seg, src)
def _pad(x, pw):
    flat = tuple(v for pair in reversed(pw) for v in pair)
    return torch.nn.functional.pad(x, flat)

kernel_name = 'concat_heads__sliding_block_cached__sliding_block_cached__decode'

def setup_inputs():

    _w = (lambda a: (lambda t: t.to(torch.bfloat16) if t.is_floating_point() else t)(torch.as_tensor(a)))
    def _A_setup():
        B, Sq, D = 1, 1, 512
        Hq, Hkv, Sk, Dh = 32, 8, 32768, 128
        assert Hq % Hkv == 0, (Hq, Hkv)
        return {
            "x": _w((lambda *s: torch.randn(*s, dtype=torch.bfloat16) * 0.8)(B, Sq, D)),
            "k_cache": _w((lambda *s: torch.randn(*s, dtype=torch.bfloat16) * 0.8)(B, Hkv, Sk, Dh)),
            "v_cache": _w((lambda *s: torch.randn(*s, dtype=torch.bfloat16) * 0.05)(B, Hkv, Sk, Dh)),
            "wq": _w((lambda *s: torch.randn(*s, dtype=torch.bfloat16) * 0.8)(D, Hq * Dh) * (D ** -0.5)),
            "wo": _w((lambda *s: torch.randn(*s, dtype=torch.bfloat16) * 0.05)(Hq * Dh, D) * ((Hq * Dh) ** -0.5)),
        }
    _A_in = _A_setup()

    def _B_setup():
        B, Sq, D = 1, 1, 512
        Hq, Hkv, Sk, Dh = 32, 8, 32768, 128
        assert Hq % Hkv == 0, (Hq, Hkv)
        return {
            "x": _w((lambda *s: torch.randn(*s, dtype=torch.bfloat16) * 0.8)(B, Sq, D)),
            "k_cache": _w((lambda *s: torch.randn(*s, dtype=torch.bfloat16) * 0.8)(B, Hkv, Sk, Dh)),
            "v_cache": _w((lambda *s: torch.randn(*s, dtype=torch.bfloat16) * 0.05)(B, Hkv, Sk, Dh)),
            "wq": _w((lambda *s: torch.randn(*s, dtype=torch.bfloat16) * 0.8)(D, Hq * Dh) * (D ** -0.5)),
            "wo": _w((lambda *s: torch.randn(*s, dtype=torch.bfloat16) * 0.05)(Hq * Dh, D) * ((Hq * Dh) ** -0.5)),
        }
    _B_in = _B_setup()

    return {
        "A_x": _A_in["x"],
        "A_k_cache": _A_in["k_cache"],
        "A_v_cache": _A_in["v_cache"],
        "A_wq": _A_in["wq"],
        "A_wo": _A_in["wo"],
        "B_x": _B_in["x"],
        "B_k_cache": _B_in["k_cache"],
        "B_v_cache": _B_in["v_cache"],
        "B_wq": _B_in["wq"],
        "B_wo": _B_in["wo"],
    }

def reference(A_x, A_k_cache, A_v_cache, A_wq, A_wo, B_x, B_k_cache, B_v_cache, B_wq, B_wo):
    def _A_ref(x, k_cache, v_cache, wq, wo):
        B, Sq, D = x.shape
        Hq, Dh = 32, 128
        Hkv, Sk = k_cache.shape[1], k_cache.shape[2]
        W = min(4096, max(256, Sk // 4))
        rep = Hq // Hkv
        q = (lambda x, *d: x.permute(*d))((x @ wq).reshape(B, Sq, Hq, Dh), 0, 2, 1, 3)
        k = (lambda x, n, axis: torch.repeat_interleave(x, n, dim=axis))(k_cache[:, :, Sk - W:, :], rep, axis=1)
        v = (lambda x, n, axis: torch.repeat_interleave(x, n, dim=axis))(v_cache[:, :, Sk - W:, :], rep, axis=1)
        scores = torch.einsum("bhqd,bhkd->bhqk", q, k) * (Dh ** -0.5)
        p = _softmax(scores, axis=-1)
        o = torch.einsum("bhqk,bhkd->bhqd", p, v)
        return (lambda x, *d: x.permute(*d))(o, 0, 2, 1, 3).reshape(B, Sq, Hq * Dh) @ wo

    def _B_ref(x, k_cache, v_cache, wq, wo):
        B, Sq, D = x.shape
        Hq, Dh = 32, 128
        Hkv, Sk = k_cache.shape[1], k_cache.shape[2]
        W = min(4096, max(256, Sk // 4))
        rep = Hq // Hkv
        q = (lambda x, *d: x.permute(*d))((x @ wq).reshape(B, Sq, Hq, Dh), 0, 2, 1, 3)
        k = (lambda x, n, axis: torch.repeat_interleave(x, n, dim=axis))(k_cache[:, :, Sk - W:, :], rep, axis=1)
        v = (lambda x, n, axis: torch.repeat_interleave(x, n, dim=axis))(v_cache[:, :, Sk - W:, :], rep, axis=1)
        scores = torch.einsum("bhqd,bhkd->bhqk", q, k) * (Dh ** -0.5)
        p = _softmax(scores, axis=-1)
        o = torch.einsum("bhqk,bhkd->bhqd", p, v)
        return (lambda x, *d: x.permute(*d))(o, 0, 2, 1, 3).reshape(B, Sq, Hq * Dh) @ wo

    a = _A_ref(A_x, A_k_cache, A_v_cache, A_wq, A_wo)
    b = _B_ref(B_x, B_k_cache, B_v_cache, B_wq, B_wo)
    return torch.concatenate([a, b], axis=-1)
```

```asm
; @launch grid=(256,1,1) block=(512,1,1) lds=124160
.amdgcn_target "amdgcn-amd-amdhsa--gfx950"
.text
.globl concat_heads__sliding_block_cached__sliding_block_cached__decode_kernel
.p2align 8
.type concat_heads__sliding_block_cached__sliding_block_cached__decode_kernel,@function
concat_heads__sliding_block_cached__sliding_block_cached__decode_kernel:
    s_cmpk_ge_u32 s2, 0x100
    s_cbranch_scc1 L_end
    s_and_b32 s3, s2, 1
    s_mul_i32 s4, s3, 40
    s_load_dwordx2 s[24:25], s[0:1], s4 offset:24
    s_load_dwordx4 s[32:35], s[0:1], s4
    s_load_dwordx2 s[36:37], s[0:1], 96
    s_getpc_b64 s[6:7]
    v_lshlrev_b32 v11, 4, v0
    v_mad_u64_u32 v[12:13], vcc, v0, 16, s[6:7]
    global_load_dword v198, v[12:13], off
    v_lshrrev_b32 v10, 3, v0
    v_cmp_gt_u32 vcc, 32, v10
    s_cbranch_vccz L_B
    v_and_b32 v11, 0x70, v11
    v_lshl_add_u32 v18, v10, 16, v11
    s_lshr_b32 s47, s2, 4
    s_and_b32 s51, s47, 7
    s_and_b32 s5, s2, 14
    s_lshl2_add_u32 s54, s5, s51
    s_lshr_b32 s50, s2, 7
    s_lshl_b32 s49, s50, 14
    s_add_u32 s54, s54, s49
    s_lshl_b32 s54, s54, 7
    s_mov_b32 s26, -1
    s_mov_b32 s27, 0x20000
    v_lshrrev_b32 v12, 4, v0
    v_and_b32 v13, 4, v0
    v_lshl_add_u32 v12, v12, 3, v13
    s_lshl_b32 s49, s50, 9
    v_lshl_add_u32 v17, v12, 2, s49
    s_waitcnt lgkmcnt(0)
    global_load_dwordx4 v[160:163], v17, s[32:33]
    buffer_load_dwordx4 v[32:35], v18, s[24:27], s54 offen nt
    s_addk_i32 s54, 0x2000
    buffer_load_dwordx4 v[36:39], v18, s[24:27], s54 offen nt
    s_addk_i32 s54, 0x2000
    buffer_load_dwordx4 v[40:43], v18, s[24:27], s54 offen nt
    s_addk_i32 s54, 0x2000
    buffer_load_dwordx4 v[44:47], v18, s[24:27], s54 offen nt
    s_addk_i32 s54, 0x2000
    buffer_load_dwordx4 v[48:51], v18, s[24:27], s54 offen nt
    s_addk_i32 s54, 0x2000
    buffer_load_dwordx4 v[52:55], v18, s[24:27], s54 offen nt
    s_addk_i32 s54, 0x2000
    buffer_load_dwordx4 v[56:59], v18, s[24:27], s54 offen nt
    s_addk_i32 s54, 0x2000
    buffer_load_dwordx4 v[60:63], v18, s[24:27], s54 offen nt
L_c0:
    v_and_b32 v12, 60, v0
    v_mov_b32 v13, 0
    ds_write_b32 v12, v13 offset:0
    s_waitcnt lgkmcnt(0)
    s_barrier
    s_lshl_b32 s63, s3, 8
    s_load_dword s61, s[36:37], s63
    s_setprio 3
    v_lshrrev_b32 v10, 6, v0
    v_and_b32 v1, 63, v0
    s_bfe_u32 s46, s2, 0x30001
    v_readfirstlane_b32 s82, v10
    v_lshrrev_b32 v2, 4, v1
    v_and_b32 v3, 15, v1
    v_lshlrev_b32 v4, 4, v1
    s_lshr_b32 s47, s2, 4
    s_lshr_b32 s50, s2, 7
    s_and_b32 s51, s47, 7
    s_and_b32 s48, s82, 3
    s_lshl_b32 s57, s48, 10
    s_mul_i32 s58, s48, 17408
    s_addk_i32 s58, 1024
    s_and_b32 s67, s47, 7
    s_lshl_b32 s67, s67, 12
    s_lshl_b32 s49, s82, 2
    s_add_u32 s49, s49, 0
    v_mov_b32 v15, s49
    v_mov_b32 v14, 0
    s_add_u32 s56, s51, 4
    s_and_b32 s56, s56, 7
    s_mov_b32 s38, 1572864
    s_mov_b32 s39, 0x20000
    s_cmp_eq_u32 s51, 3
    s_cselect_b32 s68, 57, 65
    s_sub_u32 s68, s68, s48
    s_lshl_b32 s68, s68, 10
    v_add_u32 v16, s58, v4
    v_and_b32 v10, 1, v1
    v_cmp_eq_u32 vcc, 1, v10
    v_mov_b32 v11, 0x0c0c0100
    v_mov_b32 v12, 0x01000c0c
    v_cndmask_b32 v11, v11, v12, vcc
    v_mov_b32 v12, 0x0c0c0302
    v_mov_b32 v13, 0x03020c0c
    v_cndmask_b32 v12, v12, v13, vcc
    v_and_b32 v10, 2, v1
    v_cmp_eq_u32 vcc, 2, v10
    v_mov_b32 v13, 0x0c0c0c0c
    s_lshl3_add_u32 s64, s3, s46
    v_cndmask_b32 v5, v11, v13, vcc
    v_cndmask_b32 v6, v12, v13, vcc
    v_cndmask_b32 v7, v13, v11, vcc
    v_cndmask_b32 v8, v13, v12, vcc
    s_lshl_b32 s65, s64, 12
    s_add_u32 s65, s65, 4096
    s_lshl3_add_u32 s94, s3, s56
    s_lshl2_add_u32 s94, s94, s48
    s_mul_i32 s95, s94, 256
    s_add_u32 s95, s95, 196608
    s_lshl2_add_u32 s52, s50, s48
    v_and_b32 v11, 7, v1
    v_lshlrev_b32 v11, 5, v11
    v_lshl_add_u32 v144, v2, 8, v11
    s_lshl_b32 s49, s48, 9
    s_add_u32 s80, s49, 70656
    v_add_u32 v144, s80, v144
    v_and_b32 v10, 31, v1
    s_add_u32 s80, s49, 75008
    v_lshl_add_u32 v146, v10, 4, s80
    s_mul_i32 s66, s64, 34816
    s_add_u32 s66, s66, 524288
    s_mul_i32 s84, s47, 2176
    s_add_u32 s84, s84, s66
    s_add_u32 s84, s84, s49
    s_lshl_b32 s49, s51, 1
    v_xor_b32 v10, s49, v3
    v_and_b32 v11, 1, v10
    v_lshlrev_b32 v11, 3, v11
    v_and_or_b32 v11, v10, 6, v11
    v_lshrrev_b32 v10, 3, v10
    v_or_b32 v11, v11, v10
    v_lshlrev_b32 v11, 4, v11
    v_add_u32 v147, 70656, v11
    v_lshlrev_b32 v10, 1, v2
    v_xor_b32 v10, v10, v3
    v_lshlrev_b32 v10, 4, v10
    v_lshrrev_b32 v11, 1, v3
    v_lshl_add_u32 v149, v11, 8, v10
    v_xor_b32 v150, 0x80, v149
    v_and_b32 v10, 3, v1
    v_lshrrev_b32 v11, 2, v3
    v_lshlrev_b32 v12, 4, v10
    v_lshl_add_u32 v12, v2, 6, v12
    v_mul_u32_u24 v19, 2176, v11
    v_add_u32 v19, v19, v12
    v_lshrrev_b32 v12, 1, v12
    s_lshl_b32 s49, s48, 7
    s_add_u32 s49, s49, 72704
    v_add_u32 v148, s49, v12
    v_mul_u32_u24 v12, 576, v11
    v_add_u32 v148, v148, v12
    v_lshlrev_b32 v10, 10, v10
    v_lshl_add_u32 v10, v11, 8, v10
    v_xor_b32 v11, v2, v3
    v_lshl_add_u32 v10, v11, 4, v10
    v_add_u32 v154, s58, v10
    v_xor_b32 v155, 64, v154
    v_xor_b32 v156, 0x80, v154
    v_xor_b32 v157, 0xc0, v154
    s_mov_b32 s70, 0x07060500
    s_mov_b32 s71, 0x07060501
    s_mov_b32 s72, 0x07060502
    s_mov_b32 s73, 0x07060503
    s_mov_b32 s74, 0x0c0c0400
    s_mov_b32 s75, 0x04000c0c
    s_mov_b32 s76, 0xffffff00
    s_mov_b32 s77, 0xffff0000
    s_getreg_b32 s88, hwreg(HW_REG_XCC_ID, 0, 4)
    s_lshl_b32 s85, s52, 8
    s_add_u32 s85, s85, s66
    s_add_u32 s49, s47, 3
    s_and_b32 s49, s49, 3
    s_mul_i32 s49, s49, 8704
    s_add_u32 s89, s85, s49
    s_add_u32 s49, s47, 2
    s_and_b32 s49, s49, 3
    s_mul_i32 s49, s49, 8704
    s_add_u32 s87, s85, s49
    s_add_u32 s49, s47, 1
    s_and_b32 s49, s49, 3
    s_mul_i32 s49, s49, 8704
    s_add_u32 s86, s85, s49
    s_add_u32 s49, s47, 0
    s_and_b32 s49, s49, 3
    s_mul_i32 s49, s49, 8704
    s_add_u32 s85, s85, s49
    s_xor_b32 s49, s67, 32768
    s_cmp_lt_u32 s49, s68
    s_cselect_b32 s8, 0, 0xff800000
    s_xor_b32 s49, s67, 36864
    s_cmp_lt_u32 s49, s68
    s_cselect_b32 s9, 0, 0xff800000
    s_xor_b32 s49, s67, 40960
    s_cmp_lt_u32 s49, s68
    s_cselect_b32 s10, 0, 0xff800000
    s_xor_b32 s49, s67, 45056
    s_cmp_lt_u32 s49, s68
    s_cselect_b32 s11, 0, 0xff800000
    s_xor_b32 s49, s67, 49152
    s_cmp_lt_u32 s49, s68
    s_cselect_b32 s12, 0, 0xff800000
    s_xor_b32 s49, s67, 53248
    s_cmp_lt_u32 s49, s68
    s_cselect_b32 s13, 0, 0xff800000
    s_xor_b32 s49, s67, 57344
    s_cmp_lt_u32 s49, s68
    s_cselect_b32 s14, 0, 0xff800000
    s_xor_b32 s49, s67, 61440
    s_cmp_lt_u32 s49, s68
    s_cselect_b32 s15, 0, 0xff800000
    s_mov_b32 s49, 65536
    s_cmp_lt_u32 s49, s68
    s_cselect_b32 s16, 0, 0xff800000
    s_waitcnt vmcnt(7)
    v_perm_b32 v164, v160, v160, v5
    v_perm_b32 v165, v160, v160, v7
    s_nop 1
    v_mfma_f32_16x16x16_bf16 v[20:23], v[164:165], v[32:33], 0
    v_mfma_f32_16x16x16_bf16 v[24:27], v[164:165], v[34:35], 0
    s_waitcnt vmcnt(6)
    v_perm_b32 v166, v160, v160, v6
    v_perm_b32 v167, v160, v160, v8
    s_nop 1
    v_mfma_f32_16x16x16_bf16 v[20:23], v[166:167], v[36:37], v[20:23]
    v_mfma_f32_16x16x16_bf16 v[24:27], v[166:167], v[38:39], v[24:27]
    s_waitcnt vmcnt(5)
    v_perm_b32 v164, v161, v161, v5
    v_perm_b32 v165, v161, v161, v7
    s_nop 1
    v_mfma_f32_16x16x16_bf16 v[20:23], v[164:165], v[40:41], v[20:23]
    v_mfma_f32_16x16x16_bf16 v[24:27], v[164:165], v[42:43], v[24:27]
    s_waitcnt vmcnt(4)
    v_perm_b32 v166, v161, v161, v6
    v_perm_b32 v167, v161, v161, v8
    s_nop 1
    v_mfma_f32_16x16x16_bf16 v[20:23], v[166:167], v[44:45], v[20:23]
    v_mfma_f32_16x16x16_bf16 v[24:27], v[166:167], v[46:47], v[24:27]
    s_waitcnt vmcnt(3)
    v_perm_b32 v164, v162, v162, v5
    v_perm_b32 v165, v162, v162, v7
    s_nop 1
    v_mfma_f32_16x16x16_bf16 v[20:23], v[164:165], v[48:49], v[20:23]
    v_mfma_f32_16x16x16_bf16 v[24:27], v[164:165], v[50:51], v[24:27]
    s_waitcnt vmcnt(2)
    v_perm_b32 v166, v162, v162, v6
    v_perm_b32 v167, v162, v162, v8
    s_nop 1
    v_mfma_f32_16x16x16_bf16 v[20:23], v[166:167], v[52:53], v[20:23]
    v_mfma_f32_16x16x16_bf16 v[24:27], v[166:167], v[54:55], v[24:27]
    s_waitcnt vmcnt(1)
    v_perm_b32 v164, v163, v163, v5
    v_perm_b32 v165, v163, v163, v7
    s_nop 1
    v_mfma_f32_16x16x16_bf16 v[20:23], v[164:165], v[56:57], v[20:23]
    v_mfma_f32_16x16x16_bf16 v[24:27], v[164:165], v[58:59], v[24:27]
    s_waitcnt vmcnt(0)
    v_perm_b32 v166, v163, v163, v6
    v_perm_b32 v167, v163, v163, v8
    s_nop 1
    v_mfma_f32_16x16x16_bf16 v[20:23], v[166:167], v[60:61], v[20:23]
    v_mfma_f32_16x16x16_bf16 v[24:27], v[166:167], v[62:63], v[24:27]
    s_mov_b32 exec_lo, 0xff0000ff
    s_mov_b32 exec_hi, 0
    v_mov_b32 v10, 1
    s_nop 4
    ds_write_b128 v144, v[20:23]
    ds_write_b128 v144, v[24:27] offset:16
    ds_write_b32 v15, v10
    s_mov_b64 exec, -1
    s_waitcnt lgkmcnt(0)
    s_add_u32 s61, s61, 1
    s_mul_i32 s60, s61, 0x9e3779b1
    s_and_b32 s93, s60, 0x7fffe0
    s_or_b32 s93, s93, 0x4b000000
    v_mov_b32 v9, s60
    s_and_b32 s60, s60, -16
    s_or_b32 s60, s60, s88
    v_mov_b32 v145, s60
    s_cmp_lg_u32 s48, 0
    s_cbranch_scc1 L_noqpub
    s_branch L_fw1b
L_fw1:
    s_sleep 1
L_fw1b:
    ds_read_b128 v[28:31], v14 offset:0
    s_waitcnt lgkmcnt(0)
    v_min3_u32 v10, v28, v29, v30
    v_min_u32 v10, v10, v31
    v_cmp_gt_u32 vcc, 1, v10
    s_cbranch_vccnz L_fw1
    s_lshl_b32 s49, s47, 8
    s_add_u32 s49, s49, s65
    s_add_u32 s80, s49, 65536
    ds_read_b128 v[64:67], v147 offset:0
    ds_read_b128 v[68:71], v147 offset:256
    ds_read_b128 v[72:75], v147 offset:512
    ds_read_b128 v[76:79], v147 offset:768
    ds_read_b128 v[80:83], v147 offset:1024
    ds_read_b128 v[84:87], v147 offset:1280
    ds_read_b128 v[88:91], v147 offset:1536
    ds_read_b128 v[92:95], v147 offset:1792
    s_waitcnt lgkmcnt(6)
    v_pk_add_f32 v[64:65], v[64:65], v[68:69]
    v_pk_add_f32 v[66:67], v[66:67], v[70:71]
    s_waitcnt lgkmcnt(4)
    v_pk_add_f32 v[72:73], v[72:73], v[76:77]
    v_pk_add_f32 v[74:75], v[74:75], v[78:79]
    v_pk_add_f32 v[64:65], v[64:65], v[72:73]
    v_pk_add_f32 v[66:67], v[66:67], v[74:75]
    s_waitcnt lgkmcnt(2)
    v_pk_add_f32 v[80:81], v[80:81], v[84:85]
    v_pk_add_f32 v[82:83], v[82:83], v[86:87]
    s_waitcnt lgkmcnt(0)
    v_pk_add_f32 v[88:89], v[88:89], v[92:93]
    v_pk_add_f32 v[90:91], v[90:91], v[94:95]
    v_pk_add_f32 v[80:81], v[80:81], v[88:89]
    v_pk_add_f32 v[82:83], v[82:83], v[90:91]
    v_pk_add_f32 v[64:65], v[64:65], v[80:81]
    v_pk_add_f32 v[66:67], v[66:67], v[82:83]
    v_perm_b32 v64, v64, v145, s70
    v_perm_b32 v65, v65, v145, s71
    v_perm_b32 v66, v66, v145, s72
    v_perm_b32 v67, v67, v145, s73
    s_mov_b64 exec, 0xffff
    buffer_store_dwordx4 v[64:67], v4, s[36:39], s80 offen
    buffer_store_dwordx4 v[64:67], v4, s[36:39], s49 offen sc1
    s_mov_b64 exec, -1
L_noqpub:
    s_and_b32 s49, s2, 0x8e
    s_cmp_lg_u32 s49, 0
    s_cbranch_scc1 L_noinit
    v_cmp_gt_u32 vcc, 4, v1
    v_mov_b32 v10, s93
    s_mov_b64 exec, 0xff
    v_cndmask_b32 v168, v10, 0, vcc
    v_cndmask_b32 v169, 0, v10, vcc
    v_cndmask_b32 v170, v10, 0, vcc
    v_cndmask_b32 v171, 0, v10, vcc
    v_and_b32 v11, 4, v1
    v_lshl_add_u32 v11, v11, 4, v4
    buffer_store_dwordx4 v[168:171], v11, s[36:39], s95 offen sc1
    s_mov_b64 exec, -1
L_noinit:
    s_branch L_fw2b
L_fw2:
    s_sleep 1
L_fw2b:
    ds_read_b128 v[28:31], v14 offset:16
    s_waitcnt lgkmcnt(0)
    v_min3_u32 v10, v28, v29, v30
    v_min_u32 v10, v10, v31
    v_cmp_gt_u32 vcc, 1, v10
    s_cbranch_vccnz L_fw2
    ds_read_b128 v[64:67], v154 offset:0
    ds_read_b128 v[68:71], v155 offset:0
    ds_read_b128 v[72:75], v156 offset:0
    ds_read_b128 v[76:79], v157 offset:0
    ds_read_b128 v[80:83], v154 offset:4096
    ds_read_b128 v[84:87], v155 offset:4096
    ds_read_b128 v[88:91], v156 offset:4096
    ds_read_b128 v[92:95], v157 offset:4096
    ds_read_b128 v[96:99], v154 offset:8192
    ds_read_b128 v[100:103], v155 offset:8192
    ds_read_b128 v[104:107], v156 offset:8192
    ds_read_b128 v[108:111], v157 offset:8192
    s_waitcnt lgkmcnt(4)
    ds_read_b128 v[112:115], v154 offset:12288
    ds_read_b128 v[116:119], v155 offset:12288
    ds_read_b128 v[120:123], v156 offset:12288
    ds_read_b128 v[124:127], v157 offset:12288
    ds_read_b128 v[128:131], v154 offset:16384
    ds_read_b128 v[132:135], v155 offset:16384
    ds_read_b128 v[136:139], v156 offset:16384
    ds_read_b128 v[140:143], v157 offset:16384
    v_add_u32 v12, 115968, v149
    v_add_u32 v13, 115968, v150
    s_branch L_fw3b
L_fw3:
    s_sleep 1
L_fw3b:
    ds_read_b128 v[28:31], v14 offset:16
    s_waitcnt lgkmcnt(0)
    v_min3_u32 v10, v28, v29, v30
    v_min_u32 v10, v10, v31
    v_cmp_gt_u32 vcc, 2, v10
    s_cbranch_vccnz L_fw3
    ds_read_b128 v[168:171], v12 offset:0
    ds_read_b128 v[172:175], v13 offset:0
    ds_read_b128 v[176:179], v12 offset:2048
    ds_read_b128 v[180:183], v13 offset:2048
    s_waitcnt lgkmcnt(0)
    v_perm_b32 v32, v169, v168, s74
    v_perm_b32 v33, v171, v170, s75
    v_perm_b32 v34, v173, v172, s74
    v_perm_b32 v35, v175, v174, s75
    v_perm_b32 v36, v177, v176, s74
    v_perm_b32 v37, v179, v178, s75
    v_perm_b32 v38, v181, v180, s74
    v_perm_b32 v39, v183, v182, s75
    v_bitop3_b32 v32, v32, v33, v145 bitop3:0x56
    v_bitop3_b32 v34, v34, v35, v145 bitop3:0x56
    v_bitop3_b32 v36, v36, v37, v145 bitop3:0x56
    v_bitop3_b32 v38, v38, v39, v145 bitop3:0x56
    v_or3_b32 v11, v32, v34, v36
    v_or_b32 v11, v11, v38
    v_cmp_lt_u32 vcc, 15, v11
    s_cbranch_vccz L_q_ok
    s_branch L_fw4b
L_fw4:
    s_sleep 1
L_fw4b:
    ds_read_b128 v[28:31], v14 offset:16
    s_waitcnt lgkmcnt(0)
    v_min3_u32 v10, v28, v29, v30
    v_min_u32 v10, v10, v31
    v_cmp_gt_u32 vcc, 3, v10
    s_cbranch_vccnz L_fw4
    ds_read_b128 v[168:171], v12 offset:4096
    ds_read_b128 v[172:175], v13 offset:4096
    ds_read_b128 v[176:179], v12 offset:6144
    ds_read_b128 v[180:183], v13 offset:6144
    s_waitcnt lgkmcnt(0)
    v_perm_b32 v32, v169, v168, s74
    v_perm_b32 v33, v171, v170, s75
    v_perm_b32 v34, v173, v172, s74
    v_perm_b32 v35, v175, v174, s75
    v_perm_b32 v36, v177, v176, s74
    v_perm_b32 v37, v179, v178, s75
    v_perm_b32 v38, v181, v180, s74
    v_perm_b32 v39, v183, v182, s75
    v_bitop3_b32 v32, v32, v33, v145 bitop3:0x56
    v_bitop3_b32 v34, v34, v35, v145 bitop3:0x56
    v_bitop3_b32 v36, v36, v37, v145 bitop3:0x56
    v_bitop3_b32 v38, v38, v39, v145 bitop3:0x56
    v_or3_b32 v11, v32, v34, v36
    v_or_b32 v11, v11, v38
    v_cmp_lt_u32 vcc, 15, v11
    s_cbranch_vccz L_q_ok
    s_mov_b32 s79, 524288
L_q_spin:
    buffer_load_dwordx4 v[168:171], v149, s[36:39], s65 offen sc1
    buffer_load_dwordx4 v[172:175], v150, s[36:39], s65 offen sc1
    buffer_load_dwordx4 v[176:179], v149, s[36:39], s65 offen offset:2048 sc1
    buffer_load_dwordx4 v[180:183], v150, s[36:39], s65 offen offset:2048 sc1
    s_sub_u32 s79, s79, 1
    s_cbranch_scc1 L_q_ok
    s_waitcnt vmcnt(0)
    v_perm_b32 v32, v169, v168, s74
    v_perm_b32 v33, v171, v170, s75
    v_perm_b32 v34, v173, v172, s74
    v_perm_b32 v35, v175, v174, s75
    v_perm_b32 v36, v177, v176, s74
    v_perm_b32 v37, v179, v178, s75
    v_perm_b32 v38, v181, v180, s74
    v_perm_b32 v39, v183, v182, s75
    v_bitop3_b32 v32, v32, v33, v145 bitop3:0x56
    v_bitop3_b32 v34, v34, v35, v145 bitop3:0x56
    v_bitop3_b32 v36, v36, v37, v145 bitop3:0x56
    v_bitop3_b32 v38, v38, v39, v145 bitop3:0x56
    v_or3_b32 v11, v32, v34, v36
    v_or_b32 v11, v11, v38
    v_cmp_lt_u32 vcc, 15, v11
    s_cbranch_vccnz L_q_spin
L_q_ok:
    v_cmp_ne_u32 vcc, 0, v11
    v_and_b32 v168, s76, v168
    v_and_b32 v169, s76, v169
    v_and_b32 v170, s76, v170
    v_and_b32 v171, s76, v171
    v_and_b32 v172, s76, v172
    v_and_b32 v173, s76, v173
    v_and_b32 v174, s76, v174
    v_and_b32 v175, s76, v175
    v_and_b32 v176, s76, v176
    v_and_b32 v177, s76, v177
    v_and_b32 v178, s76, v178
    v_and_b32 v179, s76, v179
    v_and_b32 v180, s76, v180
    v_and_b32 v181, s76, v181
    v_and_b32 v182, s76, v182
    v_and_b32 v183, s76, v183
    v_pk_add_f32 v[168:169], v[168:169], v[176:177]
    v_pk_add_f32 v[170:171], v[170:171], v[178:179]
    v_pk_add_f32 v[172:173], v[172:173], v[180:181]
    v_pk_add_f32 v[174:175], v[174:175], v[182:183]
    v_cvt_pk_bf16_f32 v176, v168, v169
    v_cvt_pk_bf16_f32 v177, v170, v171
    v_cvt_pk_bf16_f32 v178, v172, v173
    v_cvt_pk_bf16_f32 v179, v174, v175
    s_cmp_lg_u64 vcc, 0
    s_cselect_b32 s83, 1, 0
    v_mov_b32_dpp v32, v176 quad_perm:[0,0,0,0] row_mask:0xf bank_mask:0xf
    v_mov_b32_dpp v33, v177 quad_perm:[0,0,0,0] row_mask:0xf bank_mask:0xf
    v_mov_b32_dpp v34, v178 quad_perm:[0,0,0,0] row_mask:0xf bank_mask:0xf
    v_mov_b32_dpp v35, v179 quad_perm:[0,0,0,0] row_mask:0xf bank_mask:0xf
    v_mov_b32_dpp v36, v176 quad_perm:[1,1,1,1] row_mask:0xf bank_mask:0xf
    v_mov_b32_dpp v37, v177 quad_perm:[1,1,1,1] row_mask:0xf bank_mask:0xf
    v_mov_b32_dpp v38, v178 quad_perm:[1,1,1,1] row_mask:0xf bank_mask:0xf
    v_mov_b32_dpp v39, v179 quad_perm:[1,1,1,1] row_mask:0xf bank_mask:0xf
    v_mfma_f32_16x16x32_bf16 v[184:187], v[128:131], v[32:35], 0
    v_mfma_f32_16x16x32_bf16 v[60:63], v[112:115], v[32:35], 0
    v_mfma_f32_16x16x32_bf16 v[48:51], v[64:67], v[32:35], 0
    v_mfma_f32_16x16x32_bf16 v[52:55], v[80:83], v[32:35], 0
    v_mfma_f32_16x16x32_bf16 v[56:59], v[96:99], v[32:35], 0
    v_mov_b32_dpp v40, v176 quad_perm:[2,2,2,2] row_mask:0xf bank_mask:0xf
    v_mov_b32_dpp v41, v177 quad_perm:[2,2,2,2] row_mask:0xf bank_mask:0xf
    v_mov_b32_dpp v42, v178 quad_perm:[2,2,2,2] row_mask:0xf bank_mask:0xf
    v_mov_b32_dpp v43, v179 quad_perm:[2,2,2,2] row_mask:0xf bank_mask:0xf
    v_mfma_f32_16x16x32_bf16 v[184:187], v[132:135], v[36:39], v[184:187]
    v_mfma_f32_16x16x32_bf16 v[60:63], v[116:119], v[36:39], v[60:63]
    v_mfma_f32_16x16x32_bf16 v[48:51], v[68:71], v[36:39], v[48:51]
    v_mfma_f32_16x16x32_bf16 v[52:55], v[84:87], v[36:39], v[52:55]
    v_mfma_f32_16x16x32_bf16 v[56:59], v[100:103], v[36:39], v[56:59]
    v_mov_b32_dpp v44, v176 quad_perm:[3,3,3,3] row_mask:0xf bank_mask:0xf
    v_mov_b32_dpp v45, v177 quad_perm:[3,3,3,3] row_mask:0xf bank_mask:0xf
    v_mov_b32_dpp v46, v178 quad_perm:[3,3,3,3] row_mask:0xf bank_mask:0xf
    v_mov_b32_dpp v47, v179 quad_perm:[3,3,3,3] row_mask:0xf bank_mask:0xf
    v_mfma_f32_16x16x32_bf16 v[184:187], v[136:139], v[40:43], v[184:187]
    v_mfma_f32_16x16x32_bf16 v[60:63], v[120:123], v[40:43], v[60:63]
    v_mfma_f32_16x16x32_bf16 v[48:51], v[72:75], v[40:43], v[48:51]
    v_mfma_f32_16x16x32_bf16 v[52:55], v[88:91], v[40:43], v[52:55]
    v_mfma_f32_16x16x32_bf16 v[56:59], v[104:107], v[40:43], v[56:59]
    v_mfma_f32_16x16x32_bf16 v[184:187], v[140:143], v[44:47], v[184:187]
    v_mfma_f32_16x16x32_bf16 v[60:63], v[124:127], v[44:47], v[60:63]
    v_mfma_f32_16x16x32_bf16 v[48:51], v[76:79], v[44:47], v[48:51]
    v_mfma_f32_16x16x32_bf16 v[52:55], v[92:95], v[44:47], v[52:55]
    v_mfma_f32_16x16x32_bf16 v[56:59], v[108:111], v[44:47], v[56:59]
    v_lshrrev_b32 v12, 2, v3
    v_lshlrev_b32 v12, 5, v12
    s_lshl_b32 s49, s48, 2
    s_add_u32 s49, s49, 64
    v_add_u32 v12, s49, v12
    v_add_f32 v184, s16, v184
    v_add_f32 v63, s15, v63
    v_add_f32 v62, s14, v62
    v_add_f32 v61, s13, v61
    v_add_f32 v60, s12, v60
    v_add_f32 v59, s11, v59
    v_add_f32 v58, s10, v58
    v_add_f32 v57, s9, v57
    v_add_f32 v56, s8, v56
    v_max3_f32 v10, v184, v63, v62
    v_max3_f32 v11, v48, v49, v50
    v_max3_f32 v10, v10, v61, v60
    v_max3_f32 v11, v11, v51, v52
    v_max3_f32 v10, v10, v53, v54
    v_max3_f32 v11, v11, v55, v56
    v_max3_f32 v10, v10, v57, v58
    v_max3_f32 v10, v10, v11, v59
    v_mov_b32 v11, v10
    s_nop 1
    v_permlane16_swap_b32 v10, v11
    v_max_f32 v10, v10, v11
    v_mov_b32 v11, v10
    s_nop 1
    v_permlane32_swap_b32 v10, v11
    v_max_f32 v10, v10, v11
    s_mov_b32 s80, 0x3e0293ee
    v_mul_f32 v151, s80, v10
    v_fma_f32 v48, v48, s80, -v151
    v_fma_f32 v49, v49, s80, -v151
    v_fma_f32 v50, v50, s80, -v151
    v_fma_f32 v51, v51, s80, -v151
    v_fma_f32 v52, v52, s80, -v151
    v_fma_f32 v53, v53, s80, -v151
    v_fma_f32 v54, v54, s80, -v151
    v_fma_f32 v55, v55, s80, -v151
    v_fma_f32 v56, v56, s80, -v151
    v_fma_f32 v57, v57, s80, -v151
    v_fma_f32 v58, v58, s80, -v151
    v_fma_f32 v59, v59, s80, -v151
    v_fma_f32 v60, v60, s80, -v151
    v_fma_f32 v61, v61, s80, -v151
    v_fma_f32 v62, v62, s80, -v151
    v_fma_f32 v63, v63, s80, -v151
    v_fma_f32 v184, v184, s80, -v151
    v_exp_f32 v48, v48
    v_exp_f32 v49, v49
    v_exp_f32 v50, v50
    v_exp_f32 v51, v51
    v_exp_f32 v52, v52
    v_exp_f32 v53, v53
    v_exp_f32 v54, v54
    v_exp_f32 v55, v55
    v_exp_f32 v56, v56
    v_exp_f32 v57, v57
    v_exp_f32 v58, v58
    v_exp_f32 v59, v59
    v_exp_f32 v60, v60
    v_exp_f32 v61, v61
    v_exp_f32 v62, v62
    v_exp_f32 v63, v63
    v_exp_f32 v184, v184
    v_cvt_pk_bf16_f32 v32, v48, v49
    v_cvt_pk_bf16_f32 v33, v50, v51
    v_cvt_pk_bf16_f32 v34, v52, v53
    v_cvt_pk_bf16_f32 v35, v54, v55
    v_cvt_pk_bf16_f32 v36, v56, v57
    v_cvt_pk_bf16_f32 v37, v58, v59
    v_cvt_pk_bf16_f32 v38, v60, v61
    v_cvt_pk_bf16_f32 v39, v62, v63
    v_cvt_pk_bf16_f32 v40, v184, v184
    ds_write_b128 v16, v[32:35]
    ds_write_b128 v16, v[36:39] offset:1024
    ds_write_b32 v16, v40 offset:2048
    v_pk_add_f32 v[48:49], v[48:49], v[50:51]
    v_pk_add_f32 v[52:53], v[52:53], v[54:55]
    v_pk_add_f32 v[56:57], v[56:57], v[58:59]
    v_pk_add_f32 v[60:61], v[60:61], v[62:63]
    v_pk_add_f32 v[48:49], v[48:49], v[52:53]
    v_pk_add_f32 v[56:57], v[56:57], v[60:61]
    v_pk_add_f32 v[48:49], v[48:49], v[56:57]
    v_add_f32 v152, v48, v49
    v_add_f32 v152, v152, v184
    v_mov_b32 v11, v152
    s_nop 1
    v_permlane16_swap_b32 v152, v11
    v_add_f32 v152, v152, v11
    v_mov_b32 v11, v152
    s_nop 1
    v_permlane32_swap_b32 v152, v11
    v_add_f32 v152, v152, v11
    ds_write2_b32 v12, v151, v152 offset0:0 offset1:4
    s_lshl_b32 s49, s48, 5
    s_add_u32 s49, s49, 64
    v_mov_b32 v12, s49
    s_waitcnt lgkmcnt(0)
    s_barrier
    ds_read_b128 v[168:171], v12
    ds_read_b128 v[172:175], v12 offset:16
    s_mov_b32 s79, 524288
    v_mov_b32 v179, v9
    s_waitcnt lgkmcnt(0)
    v_max3_f32 v10, v168, v169, v170
    v_max_f32 v10, v10, v171
    v_sub_f32 v168, v168, v10
    v_sub_f32 v169, v169, v10
    v_sub_f32 v170, v170, v10
    v_sub_f32 v171, v171, v10
    v_exp_f32 v168, v168
    v_exp_f32 v169, v169
    v_exp_f32 v170, v170
    v_exp_f32 v171, v171
    v_mul_f32 v152, v168, v172
    v_fmac_f32 v152, v169, v173
    v_fmac_f32 v152, v170, v174
    v_fmac_f32 v152, v171, v175
    v_rcp_f32 v11, v152
    v_log_f32 v178, v152
    s_nop 0
    v_mul_f32 v32, v168, v11
    v_mul_f32 v33, v168, v11
    v_mul_f32 v34, v169, v11
    v_mul_f32 v35, v169, v11
    v_mul_f32 v36, v170, v11
    v_mul_f32 v37, v170, v11
    v_mul_f32 v38, v171, v11
    v_mul_f32 v39, v171, v11
    v_add_f32 v178, v178, v10
    s_mov_b32 exec_hi, 0
    s_barrier
    ds_read_b128 v[64:67], v146
    ds_read_b128 v[68:71], v146 offset:2048
    ds_read_b128 v[72:75], v146 offset:4096
    ds_read_b128 v[76:79], v146 offset:6144
    s_cmp_lg_u32 s83, 0
    s_waitcnt lgkmcnt(3)
    v_pk_mul_f32 v[64:65], v[64:65], v[32:33]
    v_pk_mul_f32 v[66:67], v[66:67], v[32:33]
    s_waitcnt lgkmcnt(2)
    v_pk_fma_f32 v[64:65], v[68:69], v[34:35], v[64:65]
    v_pk_fma_f32 v[66:67], v[70:71], v[34:35], v[66:67]
    s_waitcnt lgkmcnt(1)
    v_pk_fma_f32 v[64:65], v[72:73], v[36:37], v[64:65]
    v_pk_fma_f32 v[66:67], v[74:75], v[36:37], v[66:67]
    s_waitcnt lgkmcnt(0)
    v_pk_fma_f32 v[64:65], v[76:77], v[38:39], v[64:65]
    v_pk_fma_f32 v[66:67], v[78:79], v[38:39], v[66:67]
    v_cvt_pk_bf16_f32 v176, v64, v65
    v_cvt_pk_bf16_f32 v177, v66, v67
    s_cbranch_scc1 L_ofar
    buffer_store_dwordx4 v[176:179], v4, s[36:39], s84 offen
L_opub:
    s_mov_b64 exec, -1
    s_barrier
    buffer_load_dwordx4 v[96:99], v19, s[36:39], s85 offen sc1
    buffer_load_dwordx4 v[100:103], v19, s[36:39], s86 offen sc1
    buffer_load_dwordx4 v[104:107], v19, s[36:39], s87 offen sc1
    buffer_load_dwordx4 v[108:111], v19, s[36:39], s89 offen sc1
L_o_spin:
    s_waitcnt vmcnt(0)
    v_cmp_ne_u32 s[8:9], v99, v9
    v_cmp_ne_u32 s[10:11], v103, v9
    v_cmp_ne_u32 s[12:13], v107, v9
    v_cmp_ne_u32 s[14:15], v111, v9
    v_max3_f32 v10, v98, v102, v106
    v_max_f32 v10, v10, v110
    s_or_b64 vcc, s[8:9], s[10:11]
    s_or_b64 s[44:45], s[12:13], s[14:15]
    s_or_b64 vcc, vcc, s[44:45]
    s_cbranch_vccnz L_o_again
L_o_ok:
    v_max_f32_dpp v10, v10, v10 row_ror:4 row_mask:0xf bank_mask:0xf
    v_lshlrev_b32 v64, 16, v96
    v_and_b32 v65, s77, v96
    v_max_f32_dpp v10, v10, v10 row_ror:8 row_mask:0xf bank_mask:0xf
    v_sub_f32 v80, v98, v10
    v_sub_f32 v81, v102, v10
    v_sub_f32 v82, v106, v10
    v_sub_f32 v83, v110, v10
    v_exp_f32 v80, v80
    v_exp_f32 v81, v81
    v_exp_f32 v82, v82
    v_exp_f32 v83, v83
    v_lshlrev_b32 v66, 16, v97
    v_pk_add_f32 v[88:89], v[80:81], v[82:83]
    v_add_f32 v88, v88, v89
    v_and_b32 v67, s77, v97
    v_lshlrev_b32 v68, 16, v100
    v_add_f32_dpp v88, v88, v88 row_ror:4 row_mask:0xf bank_mask:0xf
    v_and_b32 v69, s77, v100
    v_lshlrev_b32 v70, 16, v101
    v_add_f32_dpp v88, v88, v88 row_ror:8 row_mask:0xf bank_mask:0xf
    v_rcp_f32 v88, v88
    v_and_b32 v71, s77, v101
    v_lshlrev_b32 v72, 16, v104
    v_and_b32 v73, s77, v104
    v_lshlrev_b32 v74, 16, v105
    v_and_b32 v75, s77, v105
    v_lshlrev_b32 v76, 16, v108
    v_and_b32 v77, s77, v108
    v_lshlrev_b32 v78, 16, v109
    v_and_b32 v79, s77, v109
    v_pk_mul_f32 v[80:81], v[80:81], v[88:89] op_sel_hi:[1,0]
    v_pk_mul_f32 v[82:83], v[82:83], v[88:89] op_sel_hi:[1,0]
    v_pk_mul_f32 v[64:65], v[64:65], v[80:81] op_sel:[0,0] op_sel_hi:[1,0]
    v_pk_mul_f32 v[66:67], v[66:67], v[80:81] op_sel:[0,0] op_sel_hi:[1,0]
    v_pk_fma_f32 v[64:65], v[68:69], v[80:81], v[64:65] op_sel:[0,1,0] op_sel_hi:[1,1,1]
    v_pk_fma_f32 v[66:67], v[70:71], v[80:81], v[66:67] op_sel:[0,1,0] op_sel_hi:[1,1,1]
    v_pk_fma_f32 v[64:65], v[72:73], v[82:83], v[64:65] op_sel:[0,0,0] op_sel_hi:[1,0,1]
    v_pk_fma_f32 v[66:67], v[74:75], v[82:83], v[66:67] op_sel:[0,0,0] op_sel_hi:[1,0,1]
    v_pk_fma_f32 v[64:65], v[76:77], v[82:83], v[64:65] op_sel:[0,1,0] op_sel_hi:[1,1,1]
    v_pk_fma_f32 v[66:67], v[78:79], v[82:83], v[66:67] op_sel:[0,1,0] op_sel_hi:[1,1,1]
    v_cvt_pk_bf16_f32 v72, v64, v65
    v_cvt_pk_bf16_f32 v73, v66, v67
    ds_write_b64 v148, v[72:73]
    s_waitcnt lgkmcnt(0)
    s_barrier
    s_endpgm
L_ofar:
    buffer_store_dwordx4 v[176:179], v4, s[36:39], s84 offen sc1
    s_branch L_opub
L_o_again:
    s_sub_u32 s79, s79, 1
    s_cbranch_scc1 L_o_ok
    s_mov_b64 exec, s[8:9]
    s_cbranch_execz L_om0
    buffer_load_dwordx4 v[96:99], v19, s[36:39], s85 offen sc1
L_om0:
    s_mov_b64 exec, s[10:11]
    s_cbranch_execz L_om1
    buffer_load_dwordx4 v[100:103], v19, s[36:39], s86 offen sc1
L_om1:
    s_mov_b64 exec, s[12:13]
    s_cbranch_execz L_om2
    buffer_load_dwordx4 v[104:107], v19, s[36:39], s87 offen sc1
L_om2:
    s_mov_b64 exec, s[14:15]
    s_cbranch_execz L_om3
    buffer_load_dwordx4 v[108:111], v19, s[36:39], s89 offen sc1
L_om3:
    s_mov_b64 exec, -1
    s_branch L_o_spin
    .p2align 6
L_B:
    v_and_b32 v12, 60, v0
    v_mov_b32 v13, 0
    ds_write_b32 v12, v13 offset:0
    s_waitcnt lgkmcnt(0)
    s_barrier
    s_mov_b64 s[16:17], s[34:35]
    s_load_dwordx2 s[20:21], s[0:1], s4 offset:16
    s_load_dwordx2 s[28:29], s[0:1], s4 offset:32
    s_load_dwordx2 s[40:41], s[0:1], 80
    s_lshl_b32 s63, s3, 8
    s_load_dword s61, s[36:37], s63
    v_lshrrev_b32 v10, 6, v0
    v_and_b32 v1, 63, v0
    s_bfe_u32 s46, s2, 0x30001
    v_readfirstlane_b32 s82, v10
    v_lshrrev_b32 v2, 4, v1
    v_and_b32 v3, 15, v1
    v_lshlrev_b32 v4, 4, v1
    s_lshr_b32 s47, s2, 4
    s_lshr_b32 s50, s2, 7
    s_and_b32 s51, s47, 7
    s_and_b32 s48, s82, 3
    s_lshl_b32 s57, s48, 10
    s_mul_i32 s58, s48, 17408
    s_addk_i32 s58, 1024
    s_and_b32 s67, s47, 7
    s_lshl_b32 s67, s67, 12
    s_mov_b32 s26, -1
    s_mov_b32 s27, 0x20000
    s_lshl2_add_u32 s80, s47, s48
    s_lshl_b32 s80, s80, 6
    s_add_u32 s80, s80, s46
    s_lshl_b32 s80, s80, 10
    s_add_u32 s80, s80, 33152
    v_lshrrev_b32 v10, 1, v1
    v_and_b32 v11, 1, v1
    v_lshlrev_b32 v11, 6, v11
    v_lshl_add_u32 v148, v10, 10, v11
    v_lshl_add_u32 v10, v10, 13, v11
    s_mov_b64 exec, 0xff
    buffer_load_dword v197, v10, s[24:27], s80 offen
    s_mov_b64 exec, -1
    s_mov_b32 s18, 67108864
    s_mov_b32 s19, 0x20000
    s_add_u32 s49, s47, 4
    s_lshr_b32 s49, s49, 3
    s_mul_i32 s49, s49, 8
    s_mul_i32 s55, s47, 65
    s_sub_u32 s55, s55, s49
    s_add_u32 s55, s55, s48
    s_lshl_b32 s55, s55, 10
    s_lshl_b32 s49, s46, 23
    s_add_u32 s55, s55, s49
    s_add_u32 s55, s55, 7340032
    v_lshlrev_b32 v10, 2, v2
    v_xor_b32 v10, v10, v3
    v_lshlrev_b32 v10, 4, v10
    v_lshl_add_u32 v184, v2, 8, v10
    v_xor_b32 v185, 16, v184
    v_xor_b32 v186, 32, v184
    v_xor_b32 v187, 48, v184
    s_add_u32 m0, s58, 0
    s_xor_b32 s49, s67, 0
    s_add_u32 s49, s49, s55
    buffer_load_dwordx4 v184, s[16:19], s49 offen nt lds
    s_add_u32 m0, s58, 1024
    s_xor_b32 s49, s67, 4096
    s_add_u32 s49, s49, s55
    buffer_load_dwordx4 v185, s[16:19], s49 offen nt lds
    s_add_u32 m0, s58, 2048
    s_xor_b32 s49, s67, 8192
    s_add_u32 s49, s49, s55
    buffer_load_dwordx4 v186, s[16:19], s49 offen nt lds
    s_lshl_b32 s49, s82, 2
    s_add_u32 s49, s49, 0
    v_mov_b32 v15, s49
    v_mov_b32 v14, 0
    s_add_u32 s56, s51, 4
    s_and_b32 s56, s56, 7
    s_mov_b32 s38, 1572864
    s_mov_b32 s39, 0x20000
    s_cmp_eq_u32 s51, 3
    s_cselect_b32 s68, 57, 65
    s_sub_u32 s68, s68, s48
    s_lshl_b32 s68, s68, 10
    v_add_u32 v16, s58, v4
    v_and_b32 v10, 1, v1
    v_cmp_eq_u32 vcc, 1, v10
    v_mov_b32 v11, 0x0c0c0100
    v_mov_b32 v12, 0x01000c0c
    v_cndmask_b32 v11, v11, v12, vcc
    v_mov_b32 v12, 0x0c0c0302
    v_mov_b32 v13, 0x03020c0c
    v_cndmask_b32 v12, v12, v13, vcc
    v_and_b32 v10, 2, v1
    v_cmp_eq_u32 vcc, 2, v10
    v_mov_b32 v13, 0x0c0c0c0c
    s_lshl3_add_u32 s64, s3, s46
    v_cndmask_b32 v5, v11, v13, vcc
    v_cndmask_b32 v6, v12, v13, vcc
    v_cndmask_b32 v7, v13, v11, vcc
    v_cndmask_b32 v8, v13, v12, vcc
    s_lshl_b32 s65, s64, 12
    s_add_u32 s65, s65, 4096
    s_lshl3_add_u32 s94, s3, s56
    s_lshl2_add_u32 s94, s94, s48
    s_mul_i32 s95, s94, 256
    s_add_u32 s95, s95, 196608
    s_mov_b32 s22, 67108864
    s_mov_b32 s23, 0x20000
    s_mov_b32 s30, 4194304
    s_mov_b32 s31, 0x20000
    s_mov_b32 s42, 2048
    s_mov_b32 s43, 0x20000
    s_add_u32 m0, s58, 3072
    s_xor_b32 s49, s67, 12288
    s_add_u32 s49, s49, s55
    buffer_load_dwordx4 v187, s[16:19], s49 offen nt lds
    s_add_u32 m0, s58, 4096
    s_xor_b32 s49, s67, 16384
    s_add_u32 s49, s49, s55
    buffer_load_dwordx4 v184, s[16:19], s49 offen nt lds
    s_add_u32 m0, s58, 5120
    s_xor_b32 s49, s67, 20480
    s_add_u32 s49, s49, s55
    buffer_load_dwordx4 v185, s[16:19], s49 offen nt lds
    s_add_u32 m0, s58, 6144
    s_xor_b32 s49, s67, 24576
    s_add_u32 s49, s49, s55
    buffer_load_dwordx4 v186, s[16:19], s49 offen nt lds
    s_add_u32 m0, s58, 7168
    s_xor_b32 s49, s67, 28672
    s_add_u32 s49, s49, s55
    buffer_load_dwordx4 v187, s[16:19], s49 offen nt lds
    v_lshrrev_b32 v10, 3, v1
    v_and_b32 v11, 2, v10
    v_xor_b32 v11, v11, v1
    s_and_b32 s49, s48, 1
    s_lshl_b32 s49, s49, 2
    v_xor_b32 v11, s49, v11
    v_and_b32 v11, 7, v11
    v_lshlrev_b32 v11, 4, v11
    v_lshl_add_u32 v17, v10, 10, v11
    s_lshl_b32 s59, s46, 19
    s_lshl_b32 s49, s50, 18
    s_add_u32 s59, s59, s49
    s_lshl_b32 s80, s51, 14
    s_add_u32 s80, s80, s59
    s_add_u32 s80, s80, 131456
    s_lshl_b32 s49, s48, 13
    s_add_u32 s59, s59, s49
    s_lshl_b32 s49, s56, 7
    s_add_u32 s59, s59, s49
    s_add_u32 s69, s65, s57
    s_add_u32 s69, s69, 65536
    s_lshl_b32 s49, s48, 11
    s_add_u32 s49, s49, 75008
    v_lshl_add_u32 v18, v1, 5, s49
    v_lshlrev_b32 v10, 4, v2
    v_add_u32 v144, 72704, v10
    v_and_b32 v10, 3, v1
    v_mul_u32_u24 v10, 576, v10
    v_add_u32 v144, v144, v10
    v_bfe_u32 v10, v1, 3, 2
    v_xor_b32 v10, s48, v10
    v_lshlrev_b32 v10, 5, v10
    v_lshl_add_u32 v10, v2, 10, v10
    v_bfe_u32 v11, v1, 2, 2
    v_lshl_add_u32 v10, v11, 7, v10
    v_and_b32 v11, 3, v1
    v_lshl_add_u32 v10, v11, 3, v10
    v_add_u32 v19, 83200, v10
    v_lshlrev_b32 v145, 2, v3
    v_lshl_add_u32 v145, v2, 7, v145
    v_lshlrev_b32 v147, 1, v3
    v_lshrrev_b32 v148, 1, v1
    v_lshlrev_b32 v148, 10, v148
    v_and_b32 v11, 1, v1
    v_lshl_add_u32 v148, v11, 6, v148
    s_mov_b32 s8, 0xaaaa5555
    s_mov_b32 s9, 0
    s_mov_b32 s10, 0x5555aaaa
    s_mov_b32 s11, 0
    s_lshl_b32 s81, s94, 5
    s_mov_b32 s78, 0
    s_waitcnt lgkmcnt(0)
    s_waitcnt vmcnt(7)
    s_add_u32 m0, s58, 8192
    s_xor_b32 s49, s67, 32768
    s_cmp_lt_u32 s49, s68
    s_cselect_b32 s62, 0, 0x40000000
    v_add_u32 v13, s62, v184
    s_add_u32 s49, s49, s55
    buffer_load_dwordx4 v13, s[16:19], s49 offen nt lds
    s_waitcnt vmcnt(7)
    s_add_u32 m0, s58, 9216
    s_xor_b32 s49, s67, 36864
    s_cmp_lt_u32 s49, s68
    s_cselect_b32 s62, 0, 0x40000000
    v_add_u32 v13, s62, v185
    s_add_u32 s49, s49, s55
    buffer_load_dwordx4 v13, s[16:19], s49 offen nt lds
    s_waitcnt vmcnt(7)
    s_add_u32 m0, s58, 10240
    s_xor_b32 s49, s67, 40960
    s_cmp_lt_u32 s49, s68
    s_cselect_b32 s62, 0, 0x40000000
    v_add_u32 v13, s62, v186
    s_add_u32 s49, s49, s55
    buffer_load_dwordx4 v13, s[16:19], s49 offen nt lds
    s_waitcnt vmcnt(7)
    s_add_u32 m0, s58, 11264
    s_xor_b32 s49, s67, 45056
    s_cmp_lt_u32 s49, s68
    s_cselect_b32 s62, 0, 0x40000000
    v_add_u32 v13, s62, v187
    s_add_u32 s49, s49, s55
    buffer_load_dwordx4 v13, s[16:19], s49 offen nt lds
    s_waitcnt vmcnt(7)
    s_add_u32 m0, s58, 12288
    s_xor_b32 s49, s67, 49152
    s_cmp_lt_u32 s49, s68
    s_cselect_b32 s62, 0, 0x40000000
    v_add_u32 v13, s62, v184
    s_add_u32 s49, s49, s55
    buffer_load_dwordx4 v13, s[16:19], s49 offen nt lds
    s_waitcnt vmcnt(7)
    s_add_u32 m0, s58, 13312
    s_xor_b32 s49, s67, 53248
    s_cmp_lt_u32 s49, s68
    s_cselect_b32 s62, 0, 0x40000000
    v_add_u32 v13, s62, v185
    s_add_u32 s49, s49, s55
    buffer_load_dwordx4 v13, s[16:19], s49 offen nt lds
    s_waitcnt vmcnt(7)
    s_add_u32 m0, s58, 14336
    s_xor_b32 s49, s67, 57344
    s_cmp_lt_u32 s49, s68
    s_cselect_b32 s62, 0, 0x40000000
    v_add_u32 v13, s62, v186
    s_add_u32 s49, s49, s55
    buffer_load_dwordx4 v13, s[16:19], s49 offen nt lds
    s_waitcnt vmcnt(7)
    s_add_u32 m0, s58, 15360
    s_xor_b32 s49, s67, 61440
    s_cmp_lt_u32 s49, s68
    s_cselect_b32 s62, 0, 0x40000000
    v_add_u32 v13, s62, v187
    s_add_u32 s49, s49, s55
    buffer_load_dwordx4 v13, s[16:19], s49 offen nt lds
    s_waitcnt vmcnt(9)
    s_add_u32 m0, s58, 16384
    s_mov_b32 s49, 65536
    s_cmp_lt_u32 s49, s68
    s_cselect_b32 s62, 0, 0x40000000
    v_add_u32 v13, s62, v184
    s_add_u32 s49, s49, s55
    buffer_load_dwordx4 v13, s[16:19], s49 offen nt lds
    s_waitcnt vmcnt(9)
    s_mov_b32 s49, 65536
    s_cmp_lt_u32 s49, s68
    s_cselect_b32 s62, 0, 0x40000000
    v_add_u32 v13, s62, v4
    s_add_u32 s49, s49, s55
    buffer_load_dwordx4 v[128:131], v13, s[20:23], s49 offen nt
    s_waitcnt vmcnt(9)
    s_xor_b32 s49, s67, 0
    s_add_u32 s49, s49, s55
    buffer_load_dwordx4 v[64:67], v4, s[20:23], s49 offen nt
    s_waitcnt vmcnt(9)
    s_xor_b32 s49, s67, 4096
    s_add_u32 s49, s49, s55
    buffer_load_dwordx4 v[68:71], v4, s[20:23], s49 offen nt
    s_waitcnt vmcnt(9)
    s_add_u32 m0, s57, 115968
    s_nop 0
    buffer_load_dwordx4 v4, s[36:39], s69 offen sc1 lds
    s_waitcnt vmcnt(9)
    s_xor_b32 s49, s67, 8192
    s_add_u32 s49, s49, s55
    buffer_load_dwordx4 v[72:75], v4, s[20:23], s49 offen nt
    s_waitcnt vmcnt(9)
    s_xor_b32 s49, s67, 12288
    s_add_u32 s49, s49, s55
    buffer_load_dwordx4 v[76:79], v4, s[20:23], s49 offen nt
    s_waitcnt vmcnt(9)
    s_xor_b32 s49, s67, 16384
    s_add_u32 s49, s49, s55
    buffer_load_dwordx4 v[80:83], v4, s[20:23], s49 offen nt
    s_waitcnt vmcnt(9)
    s_xor_b32 s49, s67, 20480
    s_add_u32 s49, s49, s55
    buffer_load_dwordx4 v[84:87], v4, s[20:23], s49 offen nt
    s_waitcnt vmcnt(9)
    s_add_u32 m0, s57, 120064
    s_nop 0
    buffer_load_dwordx4 v4, s[36:39], s69 offen sc1 lds
    s_waitcnt vmcnt(9)
    s_waitcnt vmcnt(9)
    v_mov_b32 v10, 1
    ds_write_b32 v15, v10
    s_xor_b32 s49, s67, 24576
    s_add_u32 s49, s49, s55
    buffer_load_dwordx4 v[88:91], v4, s[20:23], s49 offen nt
    s_waitcnt vmcnt(9)
    s_xor_b32 s49, s67, 28672
    s_add_u32 s49, s49, s55
    buffer_load_dwordx4 v[92:95], v4, s[20:23], s49 offen nt
    s_waitcnt vmcnt(9)
    s_xor_b32 s49, s67, 32768
    s_cmp_lt_u32 s49, s68
    s_cselect_b32 s62, 0, 0x40000000
    v_add_u32 v13, s62, v4
    s_add_u32 s49, s49, s55
    buffer_load_dwordx4 v[96:99], v13, s[20:23], s49 offen nt
    s_waitcnt vmcnt(9)
    s_xor_b32 s49, s67, 36864
    s_cmp_lt_u32 s49, s68
    s_cselect_b32 s62, 0, 0x40000000
    v_add_u32 v13, s62, v4
    s_add_u32 s49, s49, s55
    buffer_load_dwordx4 v[100:103], v13, s[20:23], s49 offen nt
    s_waitcnt vmcnt(9)
    s_waitcnt vmcnt(9)
    v_mov_b32 v10, 2
    ds_write_b32 v15, v10
    s_mov_b32 exec_hi, 0
    buffer_load_dword v146, v145, s[36:39], s95 offen sc1
    s_mov_b64 exec, -1
    s_waitcnt vmcnt(9)
    s_xor_b32 s49, s67, 40960
    s_cmp_lt_u32 s49, s68
    s_cselect_b32 s62, 0, 0x40000000
    v_add_u32 v13, s62, v4
    s_add_u32 s49, s49, s55
    buffer_load_dwordx4 v[104:107], v13, s[20:23], s49 offen nt
    s_waitcnt vmcnt(9)
    s_xor_b32 s49, s67, 45056
    s_cmp_lt_u32 s49, s68
    s_cselect_b32 s62, 0, 0x40000000
    v_add_u32 v13, s62, v4
    s_add_u32 s49, s49, s55
    buffer_load_dwordx4 v[108:111], v13, s[20:23], s49 offen nt
    s_waitcnt vmcnt(9)
    s_xor_b32 s49, s67, 49152
    s_cmp_lt_u32 s49, s68
    s_cselect_b32 s62, 0, 0x40000000
    v_add_u32 v13, s62, v4
    s_add_u32 s49, s49, s55
    buffer_load_dwordx4 v[112:115], v13, s[20:23], s49 offen nt
    s_waitcnt vmcnt(9)
    s_xor_b32 s49, s67, 53248
    s_cmp_lt_u32 s49, s68
    s_cselect_b32 s62, 0, 0x40000000
    v_add_u32 v13, s62, v4
    s_add_u32 s49, s49, s55
    buffer_load_dwordx4 v[116:119], v13, s[20:23], s49 offen nt
    s_waitcnt vmcnt(9)
    s_waitcnt vmcnt(9)
    v_mov_b32 v10, 3
    ds_write_b32 v15, v10
    s_xor_b32 s49, s67, 57344
    s_cmp_lt_u32 s49, s68
    s_cselect_b32 s62, 0, 0x40000000
    v_add_u32 v13, s62, v4
    s_add_u32 s49, s49, s55
    buffer_load_dwordx4 v[120:123], v13, s[20:23], s49 offen nt
    s_waitcnt vmcnt(9)
    s_xor_b32 s49, s67, 61440
    s_cmp_lt_u32 s49, s68
    s_cselect_b32 s62, 0, 0x40000000
    v_add_u32 v13, s62, v4
    s_add_u32 s49, s49, s55
    buffer_load_dwordx4 v[124:127], v13, s[20:23], s49 offen nt
    s_waitcnt vmcnt(9)
    s_lshl_b32 s49, s48, 12
    s_add_u32 s49, s49, s80
    s_mov_b64 exec, 0xff
    buffer_load_dword v197, v148, s[28:31], s49 offen
    s_mov_b64 exec, -1
    s_waitcnt lgkmcnt(0)
    s_add_u32 s61, s61, 1
    s_mul_i32 s60, s61, 0x9e3779b1
    s_and_b32 s93, s60, 0x7fffe0
    s_or_b32 s93, s93, 0x4b000000
    s_barrier
    ds_read_b128 v[152:155], v16
    ds_read_b128 v[156:159], v16 offset:1024
    ds_read_b32 v160, v16 offset:2048
    s_waitcnt lgkmcnt(0)
    v_perm_b32 v164, v160, v160, v5
    v_perm_b32 v165, v160, v160, v7
    v_perm_b32 v166, v152, v152, v5
    v_perm_b32 v167, v152, v152, v7
    s_waitcnt vmcnt(20)
    v_mfma_f32_16x16x16_bf16 v[20:23], v[164:165], v[128:129], 0
    v_mfma_f32_16x16x16_bf16 v[24:27], v[164:165], v[130:131], 0
    v_perm_b32 v168, v152, v152, v6
    v_perm_b32 v169, v152, v152, v8
    s_waitcnt vmcnt(19)
    v_mfma_f32_16x16x16_bf16 v[20:23], v[166:167], v[64:65], v[20:23]
    v_mfma_f32_16x16x16_bf16 v[24:27], v[166:167], v[66:67], v[24:27]
    v_perm_b32 v170, v153, v153, v5
    v_perm_b32 v171, v153, v153, v7
    s_waitcnt vmcnt(18)
    v_mfma_f32_16x16x16_bf16 v[20:23], v[168:169], v[68:69], v[20:23]
    v_mfma_f32_16x16x16_bf16 v[24:27], v[168:169], v[70:71], v[24:27]
    v_perm_b32 v172, v153, v153, v6
    v_perm_b32 v173, v153, v153, v8
    s_waitcnt vmcnt(16)
    v_mfma_f32_16x16x16_bf16 v[20:23], v[170:171], v[72:73], v[20:23]
    v_mfma_f32_16x16x16_bf16 v[24:27], v[170:171], v[74:75], v[24:27]
    v_perm_b32 v174, v154, v154, v5
    v_perm_b32 v175, v154, v154, v7
    s_waitcnt vmcnt(15)
    v_mfma_f32_16x16x16_bf16 v[20:23], v[172:173], v[76:77], v[20:23]
    v_mfma_f32_16x16x16_bf16 v[24:27], v[172:173], v[78:79], v[24:27]
    v_perm_b32 v176, v154, v154, v6
    v_perm_b32 v177, v154, v154, v8
    s_waitcnt vmcnt(14)
    v_mfma_f32_16x16x16_bf16 v[20:23], v[174:175], v[80:81], v[20:23]
    v_mfma_f32_16x16x16_bf16 v[24:27], v[174:175], v[82:83], v[24:27]
    v_perm_b32 v178, v155, v155, v5
    v_perm_b32 v179, v155, v155, v7
    s_waitcnt vmcnt(13)
    v_mfma_f32_16x16x16_bf16 v[20:23], v[176:177], v[84:85], v[20:23]
    v_mfma_f32_16x16x16_bf16 v[24:27], v[176:177], v[86:87], v[24:27]
    v_perm_b32 v164, v155, v155, v6
    v_perm_b32 v165, v155, v155, v8
    s_waitcnt vmcnt(11)
    v_mfma_f32_16x16x16_bf16 v[20:23], v[178:179], v[88:89], v[20:23]
    v_mfma_f32_16x16x16_bf16 v[24:27], v[178:179], v[90:91], v[24:27]
    v_perm_b32 v166, v156, v156, v5
    v_perm_b32 v167, v156, v156, v7
    s_waitcnt vmcnt(10)
    v_mfma_f32_16x16x16_bf16 v[20:23], v[164:165], v[92:93], v[20:23]
    v_mfma_f32_16x16x16_bf16 v[24:27], v[164:165], v[94:95], v[24:27]
    v_perm_b32 v168, v156, v156, v6
    v_perm_b32 v169, v156, v156, v8
    s_waitcnt vmcnt(9)
    v_mfma_f32_16x16x16_bf16 v[20:23], v[166:167], v[96:97], v[20:23]
    v_mfma_f32_16x16x16_bf16 v[24:27], v[166:167], v[98:99], v[24:27]
    v_perm_b32 v170, v157, v157, v5
    v_perm_b32 v171, v157, v157, v7
    s_waitcnt vmcnt(8)
    v_mfma_f32_16x16x16_bf16 v[20:23], v[168:169], v[100:101], v[20:23]
    v_mfma_f32_16x16x16_bf16 v[24:27], v[168:169], v[102:103], v[24:27]
    v_perm_b32 v172, v157, v157, v6
    v_perm_b32 v173, v157, v157, v8
    s_waitcnt vmcnt(6)
    v_mfma_f32_16x16x16_bf16 v[20:23], v[170:171], v[104:105], v[20:23]
    v_mfma_f32_16x16x16_bf16 v[24:27], v[170:171], v[106:107], v[24:27]
    v_perm_b32 v174, v158, v158, v5
    v_perm_b32 v175, v158, v158, v7
    s_waitcnt vmcnt(5)
    v_mfma_f32_16x16x16_bf16 v[20:23], v[172:173], v[108:109], v[20:23]
    v_mfma_f32_16x16x16_bf16 v[24:27], v[172:173], v[110:111], v[24:27]
    s_add_u32 m0, s57, 83200
    s_add_u32 s49, s59, 0
    buffer_load_dwordx4 v17, s[28:31], s49 offen nt lds
    v_perm_b32 v176, v158, v158, v6
    v_perm_b32 v177, v158, v158, v8
    s_waitcnt vmcnt(5)
    v_mfma_f32_16x16x16_bf16 v[20:23], v[174:175], v[112:113], v[20:23]
    v_mfma_f32_16x16x16_bf16 v[24:27], v[174:175], v[114:115], v[24:27]
    s_add_u32 m0, s57, 87296
    s_add_u32 s49, s59, 32768
    buffer_load_dwordx4 v17, s[28:31], s49 offen nt lds
    v_perm_b32 v178, v159, v159, v5
    v_perm_b32 v179, v159, v159, v7
    s_waitcnt vmcnt(5)
    v_mfma_f32_16x16x16_bf16 v[20:23], v[176:177], v[116:117], v[20:23]
    v_mfma_f32_16x16x16_bf16 v[24:27], v[176:177], v[118:119], v[24:27]
    s_add_u32 m0, s57, 91392
    s_add_u32 s49, s59, 65536
    buffer_load_dwordx4 v17, s[28:31], s49 offen nt lds
    v_perm_b32 v164, v159, v159, v6
    v_perm_b32 v165, v159, v159, v8
    s_waitcnt vmcnt(5)
    v_mfma_f32_16x16x16_bf16 v[20:23], v[178:179], v[120:121], v[20:23]
    v_mfma_f32_16x16x16_bf16 v[24:27], v[178:179], v[122:123], v[24:27]
    s_add_u32 m0, s57, 95488
    s_add_u32 s49, s59, 98304
    buffer_load_dwordx4 v17, s[28:31], s49 offen nt lds
    s_waitcnt vmcnt(5)
    v_mfma_f32_16x16x16_bf16 v[20:23], v[164:165], v[124:125], v[20:23]
    v_mfma_f32_16x16x16_bf16 v[24:27], v[164:165], v[126:127], v[24:27]
    s_add_u32 m0, s57, 99584
    s_add_u32 s49, s59, 131072
    buffer_load_dwordx4 v17, s[28:31], s49 offen nt lds
    s_nop 3
    ds_write_b128 v18, v[20:23]
    ds_write_b128 v18, v[24:27] offset:16
    s_waitcnt lgkmcnt(0)
    s_barrier
    s_add_u32 m0, s57, 103680
    s_add_u32 s49, s59, 163840
    buffer_load_dwordx4 v17, s[28:31], s49 offen nt lds
    s_add_u32 m0, s57, 107776
    s_add_u32 s49, s59, 196608
    buffer_load_dwordx4 v17, s[28:31], s49 offen nt lds
    s_add_u32 m0, s57, 111872
    s_add_u32 s49, s59, 229376
    buffer_load_dwordx4 v17, s[28:31], s49 offen nt lds
    s_barrier
    s_mov_b32 s79, 524288
L_chk:
    v_subrev_u32 v10, s93, v146
    v_cmp_lt_u32 vcc, 15, v10
    s_and_b64 vcc, vcc, s[10:11]
    s_cbranch_vccz L_chk_ok
    s_sub_u32 s79, s79, 1
    s_cbranch_scc1 L_chk_ok
    s_mov_b32 exec_hi, 0
    buffer_load_dword v146, v145, s[36:39], s95 offen sc1
    s_mov_b64 exec, -1
    s_waitcnt vmcnt(0)
    s_branch L_chk
L_chk_ok:

    s_add_u32 s93, s93, 15
    v_mov_b32 v11, 99
    s_waitcnt vmcnt(0)
    ds_write_b32 v15, v11
L_fw5:
    ds_read_b128 v[28:31], v14 offset:16
    s_waitcnt lgkmcnt(0)
    v_min3_u32 v10, v28, v29, v30
    v_min_u32 v10, v10, v31
    v_cmp_gt_u32 vcc, 99, v10
    s_cbranch_vccnz L_fw5
    ds_read_b64_tr_b16 v[32:33], v19 offset:0
    ds_read_b64_tr_b16 v[34:35], v19 offset:512
    ds_read_b64_tr_b16 v[36:37], v19 offset:4096
    ds_read_b64_tr_b16 v[38:39], v19 offset:4608
    ds_read_b64_tr_b16 v[40:41], v19 offset:8192
    ds_read_b64_tr_b16 v[42:43], v19 offset:8704
    ds_read_b64_tr_b16 v[44:45], v19 offset:12288
    ds_read_b64_tr_b16 v[46:47], v19 offset:12800
    ds_read_b64_tr_b16 v[48:49], v19 offset:16384
    ds_read_b64_tr_b16 v[50:51], v19 offset:16896
    ds_read_b64_tr_b16 v[52:53], v19 offset:20480
    ds_read_b64_tr_b16 v[54:55], v19 offset:20992
    s_waitcnt lgkmcnt(4)
    ds_read_b64_tr_b16 v[56:57], v19 offset:24576
    ds_read_b64_tr_b16 v[58:59], v19 offset:25088
    ds_read_b64_tr_b16 v[60:61], v19 offset:28672
    ds_read_b64_tr_b16 v[62:63], v19 offset:29184
    s_waitcnt lgkmcnt(0)
    s_barrier
    ds_read_b128 v[64:67], v144 offset:0
    ds_read_b128 v[68:71], v144 offset:64
    ds_read_b128 v[72:75], v144 offset:128
    ds_read_b128 v[76:79], v144 offset:192
    ds_read_b128 v[80:83], v144 offset:256
    ds_read_b128 v[84:87], v144 offset:320
    ds_read_b128 v[88:91], v144 offset:384
    ds_read_b128 v[92:95], v144 offset:448
    s_waitcnt lgkmcnt(7)
    v_mfma_f32_16x16x32_bf16 v[20:23], v[64:67], v[32:35], 0
    s_waitcnt lgkmcnt(6)
    s_nop 0
    v_mfma_f32_16x16x32_bf16 v[20:23], v[68:71], v[36:39], v[20:23]
    s_waitcnt lgkmcnt(5)
    s_nop 0
    v_mfma_f32_16x16x32_bf16 v[20:23], v[72:75], v[40:43], v[20:23]
    s_waitcnt lgkmcnt(4)
    s_nop 0
    v_mfma_f32_16x16x32_bf16 v[20:23], v[76:79], v[44:47], v[20:23]
    s_waitcnt lgkmcnt(3)
    s_nop 0
    v_mfma_f32_16x16x32_bf16 v[20:23], v[80:83], v[48:51], v[20:23]
    s_waitcnt lgkmcnt(2)
    s_nop 0
    v_mfma_f32_16x16x32_bf16 v[20:23], v[84:87], v[52:55], v[20:23]
    s_waitcnt lgkmcnt(1)
    s_nop 0
    v_mfma_f32_16x16x32_bf16 v[20:23], v[88:91], v[56:59], v[20:23]
    s_waitcnt lgkmcnt(0)
    s_nop 0
    v_mfma_f32_16x16x32_bf16 v[20:23], v[92:95], v[60:63], v[20:23]
    s_mov_b32 exec_hi, 0
    s_nop 6
    v_pk_add_f32 v[20:21], v[20:21], v[22:23]
    v_add_f32 v20, v20, v21
    v_cndmask_b32 v11, 1.0, v20, s[8:9]
    buffer_atomic_add_f32 v11, v145, s[36:39], s95 offen sc0
    s_waitcnt vmcnt(0)
    v_mov_b32_dpp v12, v11 quad_perm:[1,0,3,2] row_mask:0xf bank_mask:0xf
    v_add_f32 v11, v11, v20
    v_cmp_eq_u32 vcc, s93, v12
    v_cvt_pk_bf16_f32 v11, v11, v11
    s_and_b64 exec, vcc, s[8:9]
    s_cbranch_execz L_done
    buffer_store_short v11, v147, s[40:43], s81 offen
    s_and_b32 s49, s94, 31
    s_cmp_lg_u32 s49, 0
    s_cbranch_scc1 L_done
    s_and_b64 exec, exec, 1
    s_cbranch_execz L_done
    v_mov_b32 v11, s61
    buffer_store_dword v11, v147, s[36:39], s63 offen
L_done:
L_end:
    s_endpgm
    .fill (8192 + 64 - (. - concat_heads__sliding_block_cached__sliding_block_cached__decode_kernel)) / 4 * ((. - concat_heads__sliding_block_cached__sliding_block_cached__decode_kernel) < 8192 + 64) * -1, 4, 0xbf810000

.section .rodata,"a"
.p2align 6
.amdhsa_kernel concat_heads__sliding_block_cached__sliding_block_cached__decode_kernel
  .amdhsa_next_free_vgpr 200
  .amdhsa_next_free_sgpr 96
  .amdhsa_accum_offset 200
  .amdhsa_group_segment_fixed_size 0
  .amdhsa_kernarg_size 104
  .amdhsa_user_sgpr_count 2
  .amdhsa_user_sgpr_kernarg_segment_ptr 1
  .amdhsa_system_sgpr_workgroup_id_x 1
.end_amdhsa_kernel
```
